```python
import torch

def _softmax(x, axis=-1):
    return torch.softmax(x, dim=axis)
def _gelu(x):
    return torch.nn.functional.gelu(x, approximate="tanh")
def _silu(x):
    return torch.nn.functional.silu(x)
def _sigmoid(x):
    return torch.sigmoid(x)
def _layernorm(x, axis=-1, eps=1e-5):
    m = x.mean(dim=axis, keepdim=True)
    v = x.var(dim=axis, keepdim=True, unbiased=False)
    return (x - m) / torch.sqrt(v + eps)
def _scatter_add(tgt, idx, src, axis=0):
    return tgt.clone().index_add_(axis, idx, src)
def _segment_sum(src, seg, n):
    out = torch.zeros((n,) + src.shape[1:], dtype=src.dtype)
    return out.index_add_(0, seg, src)
def _pad(x, pw):
    flat = tuple(v for pair in reversed(pw) for v in pair)
    return torch.nn.functional.pad(x, flat)

kernel_name = 'gated_mix__sliding_block_cached__glu_gated_reglu__decode'

def setup_inputs():

    _w = (lambda a: (lambda t: t.to(torch.bfloat16) if t.is_floating_point() else t)(torch.as_tensor(a)))
    def _A_setup():
        B, Sq, D = 1, 1, 512
        Hq, Hkv, Sk, Dh = 32, 32, 8192, 128
        assert Hq % Hkv == 0, (Hq, Hkv)
        return {
            "x": _w((lambda *s: torch.randn(*s, dtype=torch.bfloat16) * 0.05)(B, Sq, D)),
            "k_cache": _w((lambda *s: torch.randn(*s, dtype=torch.bfloat16) * 6.4)(B, Hkv, Sk, Dh)),
            "v_cache": _w((lambda *s: torch.randn(*s, dtype=torch.bfloat16) * 0.05)(B, Hkv, Sk, Dh)),
            "wq": _w((lambda *s: torch.randn(*s, dtype=torch.bfloat16) * 6.4)(D, Hq * Dh) * (D ** -0.5)),
            "wo": _w((lambda *s: torch.randn(*s, dtype=torch.bfloat16) * 0.05)(Hq * Dh, D) * ((Hq * Dh) ** -0.5)),
        }
    _A_in = _A_setup()

    def _B_setup():
        B, S, D, F = 1, 1, 512, 1376
        return {
            "x": _w((lambda *s: torch.randn(*s, dtype=torch.bfloat16) * 0.05)(B, S, D)),
            "W_gate": _w((lambda *s: torch.randn(*s, dtype=torch.bfloat16) * 0.8)(D, F) * (2.0 / D) ** 0.5),
            "W_up": _w((lambda *s: torch.randn(*s, dtype=torch.bfloat16) * 0.8)(D, F) * (2.0 / D) ** 0.5),
            "W_down": _w((lambda *s: torch.randn(*s, dtype=torch.bfloat16) * 0.8)(F, D) * (1.0 / F) ** 0.5),
        }
    _B_in = _B_setup()

    return {
        "A_x": _A_in["x"],
        "A_k_cache": _A_in["k_cache"],
        "A_v_cache": _A_in["v_cache"],
        "A_wq": _A_in["wq"],
        "A_wo": _A_in["wo"],
        "B_x": _B_in["x"],
        "B_W_gate": _B_in["W_gate"],
        "B_W_up": _B_in["W_up"],
        "B_W_down": _B_in["W_down"],
        "gate_w": _w((lambda *s: torch.randn(*s, dtype=torch.bfloat16) * 0.1)(512) * 16.0),
    }

def reference(A_x, A_k_cache, A_v_cache, A_wq, A_wo, B_x, B_W_gate, B_W_up, B_W_down, gate_w):
    def _A_ref(x, k_cache, v_cache, wq, wo):
        B, Sq, D = x.shape
        Hq, Dh = 32, 128
        Hkv, Sk = k_cache.shape[1], k_cache.shape[2]
        W = min(4096, max(256, Sk // 4))
        rep = Hq // Hkv
        q = (lambda x, *d: x.permute(*d))((x @ wq).reshape(B, Sq, Hq, Dh), 0, 2, 1, 3)
        k = (lambda x, n, axis: torch.repeat_interleave(x, n, dim=axis))(k_cache[:, :, Sk - W:, :], rep, axis=1)
        v = (lambda x, n, axis: torch.repeat_interleave(x, n, dim=axis))(v_cache[:, :, Sk - W:, :], rep, axis=1)
        scores = torch.einsum("bhqd,bhkd->bhqk", q, k) * (Dh ** -0.5)
        p = _softmax(scores, axis=-1)
        o = torch.einsum("bhqk,bhkd->bhqd", p, v)
        return (lambda x, *d: x.permute(*d))(o, 0, 2, 1, 3).reshape(B, Sq, Hq * Dh) @ wo

    def _B_ref(x, W_gate, W_up, W_down):
        gate = torch.einsum("bsd,df->bsf", x, W_gate)
        up = torch.einsum("bsd,df->bsf", x, W_up)
        gate = gate * (lambda x, dt: x.to(dt))(gate > 0, gate.dtype)
        h = gate * up
        return torch.einsum("bsf,fd->bsd", h, W_down)

    x = A_x
    g = _sigmoid((x * gate_w).sum(-1, keepdims=True))
    a = _A_ref(x, A_k_cache, A_v_cache, A_wq, A_wo)
    b = _B_ref(x, B_W_gate, B_W_up, B_W_down)
    return g * a + (1 - g) * b
```

```asm
; @launch grid=(256,1,1) block=(768,1,1) lds=7936
.amdgcn_target "amdgcn-amd-amdhsa--gfx950"
.text
.p2align 12
.fill 64, 4, 0xbf810000
.globl gated_mix__sliding_block_cached__glu_gated_reglu__decode_kernel
.p2align 8
.type gated_mix__sliding_block_cached__glu_gated_reglu__decode_kernel,@function
gated_mix__sliding_block_cached__glu_gated_reglu__decode_kernel:
    s_load_dwordx16 s[4:19], s[0:1], 0
    s_load_dwordx8 s[20:27], s[0:1], 64
    s_load_dwordx2 s[28:29], s[0:1], 96
    s_cmp_ge_u32 s2, 256
    s_cbranch_scc1 L_end
    v_lshrrev_b32 v1, 6, v0
    v_and_b32 v0, 63, v0
    v_readfirstlane_b32 s3, v1
    s_lshr_b32 s30, s2, 5
    s_xor_b32 s30, s30, 3
    s_and_b32 s31, s2, 7
    s_bfe_u32 s52, s2, 0x20003
    s_lshl2_add_u32 s31, s31, s52
    s_mov_b32 s35, 0x20000
    s_mov_b32 s39, 0x20000
    s_mov_b32 s93, 400000
    s_cmp_lt_u32 s3, 4
    s_cbranch_scc1 L_f
    v_mov_b32 v8, 0
    ds_write_b32 v8, v8 offset:520
    s_sub_u32 s3, s3, 4
    s_lshl_b32 s52, s30, 16
    s_lshl_b32 s53, s31, 21
    s_add_u32 s52, s52, s53
    s_add_u32 s52, s52, 0x180000
    v_lshl_add_u32 v1, v0, 4, s52
    s_lshl1_add_u32 s54, s30, s31
    s_lshl2_add_u32 s54, s54, s3
    s_lshl_b32 s54, s54, 10
    s_mov_b32 s55, 0xffff
    s_movk_i32 s56, 0x2000
    s_and_b32 s54, s54, s55
    s_mov_b32 s34, 0x4000000
    s_mov_b32 s38, 0x4000000
    s_waitcnt lgkmcnt(0)
    s_mov_b32 s32, s6
    s_and_b32 s33, s7, s55
    s_mov_b32 s36, s8
    s_and_b32 s37, s9, s55
    buffer_load_dwordx4 v[32:35], v1, s[32:35], s54 offen
    s_add_u32 s54, s54, s56
    s_and_b32 s54, s54, s55
    s_barrier
    buffer_load_dwordx4 v[36:39], v1, s[32:35], s54 offen
    s_add_u32 s54, s54, s56
    s_and_b32 s54, s54, s55
    buffer_load_dwordx4 v[40:43], v1, s[32:35], s54 offen
    s_add_u32 s54, s54, s56
    s_and_b32 s54, s54, s55
    s_mov_b64 exec, 0
    s_cmp_eq_u32 s3, 0
    s_cbranch_scc1 PAD0
    s_cmp_eq_u32 s3, 1
    s_cbranch_scc1 PAD1
    s_cmp_eq_u32 s3, 2
    s_cbranch_scc1 PAD2
    s_cmp_eq_u32 s3, 3
    s_cbranch_scc1 PAD3
    s_cmp_eq_u32 s3, 4
    s_cbranch_scc1 PAD4
    s_cmp_eq_u32 s3, 5
    s_cbranch_scc1 L_back
L_back:
    s_mov_b64 exec, -1
    s_branch L_kv
L_f:
    v_lshrrev_b32 v9, 3, v0
    v_and_b32 v10, 7, v0
    s_min_u32 s46, s31, 12
    s_mul_i32 s47, s31, 5
    s_add_u32 s46, s46, s47
    s_cmp_lt_u32 s31, 12
    s_cselect_b32 s47, 6, 5
    s_lshl_b32 s52, s31, 8
    s_lshl_b32 s53, s3, 7
    s_add_u32 s52, s52, s53
    s_lshl_b32 s53, s46, 4
    s_cmp_lt_u32 s3, 2
    s_cselect_b32 s52, s52, s53
    s_movk_i32 s53, 2752
    s_cselect_b32 s53, 0x2000, s53
    s_cselect_b32 s54, 8, s47
    s_mov_b32 s34, 1409024
    s_cselect_b32 s34, 0x400000, s34
    s_lshl_b32 s55, s30, 3
    v_add_u32 v1, s55, v9
    v_lshlrev_b32 v2, 4, v1
    v_lshlrev_b32 v1, 3, v1
    v_mul_lo_u32 v1, v1, s53
    v_cmp_gt_u32 vcc, s54, v10
    v_lshl_add_u32 v1, v10, 4, v1
    v_add_u32 v1, s52, v1
    v_mov_b32 v3, 0x40000000
    v_cndmask_b32 v1, v3, v1, vcc
    s_mov_b32 s55, 0
    s_waitcnt lgkmcnt(0)
    global_load_dwordx4 v[12:15], v2, s[4:5]
    s_cmp_eq_u32 s3, 2
    s_cselect_b64 s[32:33], s[16:17], s[18:19]
    s_cmp_lt_u32 s3, 2
    s_cselect_b64 s[32:33], s[10:11], s[32:33]
    s_and_b32 s33, s33, 0xffff
    buffer_load_dwordx4 v[16:19], v1, s[32:35], s55 offen
    s_add_u32 s55, s55, s53
    buffer_load_dwordx4 v[20:23], v1, s[32:35], s55 offen
    s_add_u32 s55, s55, s53
    buffer_load_dwordx4 v[24:27], v1, s[32:35], s55 offen
    s_add_u32 s55, s55, s53
    buffer_load_dwordx4 v[28:31], v1, s[32:35], s55 offen
    s_add_u32 s55, s55, s53
    buffer_load_dwordx4 v[32:35], v1, s[32:35], s55 offen
    s_add_u32 s55, s55, s53
    buffer_load_dwordx4 v[36:39], v1, s[32:35], s55 offen
    s_add_u32 s55, s55, s53
    buffer_load_dwordx4 v[40:43], v1, s[32:35], s55 offen
    s_add_u32 s55, s55, s53
    buffer_load_dwordx4 v[44:47], v1, s[32:35], s55 offen
    s_barrier
    s_and_b32 s62, s2, 31
    s_lshl_b32 s90, s62, 7
    s_load_dword s40, s[28:29], s90
    s_mov_b32 s48, s28
    s_and_b32 s49, s29, 0xffff
    s_mov_b32 s50, 1064960
    s_mov_b32 s51, 0x20000
    s_mov_b32 s36, s20
    s_and_b32 s37, s21, 0xffff
    s_mov_b32 s38, 1409024
    s_cmp_lg_u32 s3, 3
    s_cbranch_scc1 L_f_nog1
    v_lshlrev_b32 v2, 4, v0
    global_load_dwordx4 v[84:87], v2, s[4:5]
    global_load_dwordx4 v[88:91], v2, s[22:23]
L_f_nog1:
    v_and_b32 v2, 1, v0
    v_lshlrev_b32 v2, 4, v2
    v_mov_b32 v3, 0xffff
    v_lshlrev_b32 v2, v2, v3
    v_bfe_u32 v3, v0, 1, 2
    v_cmp_eq_u32 vcc, 0, v3
    s_nop 1
    v_cndmask_b32 v4, 0, v2, vcc
    v_cmp_eq_u32 vcc, 1, v3
    s_nop 1
    v_cndmask_b32 v5, 0, v2, vcc
    v_cmp_eq_u32 vcc, 2, v3
    s_nop 1
    v_cndmask_b32 v6, 0, v2, vcc
    v_cmp_eq_u32 vcc, 3, v3
    s_nop 1
    v_cndmask_b32 v7, 0, v2, vcc
    v_mov_b32 v8, 0xff
    v_mov_b32 v92, 0
    s_mov_b32 s63, 0x0c0c0400
    s_lshl2_add_u32 s56, s62, s3
    s_lshl_b32 s56, s56, 11
    s_add_u32 s56, s56, 4096
    s_lshl4_add_u32 s57, s30, s56
    v_lshrrev_b32 v1, 4, v0
    v_lshl_add_u32 v1, v10, 1, v1
    v_lshlrev_b32 v1, 7, v1
    v_lshlrev_b32 v2, 4, v0
    s_mov_b32 s60, 0x01000100
    s_mov_b32 s61, 0x03020302
    s_mov_b32 s59, 0
    s_cmp_lt_u32 s3, 2
    s_mov_b32 s98, 0x003f003f
    s_cselect_b32 s98, 0x00ff00ff, s98
    s_cselect_b32 s95, -1, 0
    s_and_b32 s91, s3, 1
    s_lshl1_add_u32 s96, s30, s91
    s_lshl_b32 s96, s96, 10
    s_add_u32 s96, s96, 1048576
    s_cmp_eq_u32 s62, s30
    s_cselect_b32 s91, s3, 0
    s_cmp_lg_u32 s91, 2
    s_cbranch_scc1 L_f_noinit
    v_mov_b32 v93, 0
    v_mov_b32 v94, 0
    v_mov_b32 v95, 0
    v_lshlrev_b32 v11, 4, v10
    v_lshl_add_u32 v11, v9, 8, v11
    buffer_store_dwordx4 v[92:95], v11, s[48:51], s96 offen sc1
L_f_noinit:
    s_lshl_b32 s58, s30, 2
    s_waitcnt vmcnt(8)
    v_perm_b32 v11, v12, v12, s60
    v_and_b32 v48, v11, v4
    v_and_b32 v49, v11, v5
    v_and_b32 v50, v11, v6
    v_and_b32 v51, v11, v7
    v_perm_b32 v11, v12, v12, s61
    v_and_b32 v52, v11, v4
    v_and_b32 v53, v11, v5
    v_and_b32 v54, v11, v6
    v_and_b32 v55, v11, v7
    v_perm_b32 v11, v13, v13, s60
    v_and_b32 v56, v11, v4
    v_and_b32 v57, v11, v5
    v_and_b32 v58, v11, v6
    v_and_b32 v59, v11, v7
    v_perm_b32 v11, v13, v13, s61
    v_and_b32 v60, v11, v4
    v_and_b32 v61, v11, v5
    v_and_b32 v62, v11, v6
    v_and_b32 v63, v11, v7
    v_perm_b32 v11, v14, v14, s60
    v_and_b32 v64, v11, v4
    v_and_b32 v65, v11, v5
    v_and_b32 v66, v11, v6
    v_and_b32 v67, v11, v7
    v_perm_b32 v11, v14, v14, s61
    v_and_b32 v68, v11, v4
    v_and_b32 v69, v11, v5
    v_and_b32 v70, v11, v6
    v_and_b32 v71, v11, v7
    v_perm_b32 v11, v15, v15, s60
PAD0:
    s_cbranch_execz L_back
    v_and_b32 v72, v11, v4
    v_and_b32 v73, v11, v5
    v_and_b32 v74, v11, v6
    v_and_b32 v75, v11, v7
    v_perm_b32 v11, v15, v15, s61
    v_and_b32 v76, v11, v4
    v_and_b32 v77, v11, v5
    v_and_b32 v78, v11, v6
    v_and_b32 v79, v11, v7
    v_mov_b32 v94, s58
    s_waitcnt lgkmcnt(0)
    s_getreg_b32 s99, hwreg(HW_REG_XCC_ID, 0, 4)
    s_lshl_b32 s99, s99, 28
    s_add_u32 s94, s40, 0x01010101
    s_xor_b32 s40, s94, s99
    s_lshr_b32 s41, s40, 8
    s_lshr_b32 s42, s40, 16
    s_lshr_b32 s43, s40, 24
    s_waitcnt vmcnt(0)
    s_cmp_lg_u32 s91, 2
    s_cbranch_scc1 L_f_noflag
    s_mov_b64 exec, 1
    global_store_dword v94, v8, s[26:27] sc1
    s_mov_b64 exec, -1
L_f_noflag:
    v_mfma_f32_16x16x32_bf16 v[80:83], v[48:51], v[16:19], 0
    v_mfma_f32_16x16x32_bf16 v[80:83], v[52:55], v[20:23], v[80:83]
    v_mfma_f32_16x16x32_bf16 v[80:83], v[56:59], v[24:27], v[80:83]
    v_mfma_f32_16x16x32_bf16 v[80:83], v[60:63], v[28:31], v[80:83]
    v_mfma_f32_16x16x32_bf16 v[80:83], v[64:67], v[32:35], v[80:83]
    v_mfma_f32_16x16x32_bf16 v[80:83], v[68:71], v[36:39], v[80:83]
    v_mfma_f32_16x16x32_bf16 v[80:83], v[72:75], v[40:43], v[80:83]
    v_mfma_f32_16x16x32_bf16 v[80:83], v[76:79], v[44:47], v[80:83]
    s_nop 7
    v_permlane32_swap_b32 v80, v12
    v_permlane32_swap_b32 v81, v13
    v_permlane32_swap_b32 v82, v14
    v_permlane32_swap_b32 v83, v15
    v_add_f32_dpp v80, v12, v80 row_ror:8 row_mask:0xf bank_mask:0xf
    v_add_f32_dpp v81, v13, v81 row_ror:8 row_mask:0xf bank_mask:0xf
    v_add_f32_dpp v82, v14, v82 row_ror:8 row_mask:0xf bank_mask:0xf
    v_add_f32_dpp v83, v15, v83 row_ror:8 row_mask:0xf bank_mask:0xf
    v_bfi_b32 v80, v8, s40, v80
    v_bfi_b32 v81, v8, s41, v81
    v_bfi_b32 v82, v8, s42, v82
    v_bfi_b32 v83, v8, s43, v83
    s_mov_b32 exec_lo, s98
    s_mov_b32 exec_hi, 0
    buffer_store_dwordx4 v[80:83], v1, s[48:51], s57 offen
    s_mov_b64 exec, -1
    s_cmp_lg_u32 s3, 3
    s_cbranch_scc1 L_f_nog2
    v_lshlrev_b32 v16, 16, v84
    v_and_b32 v17, 0xffff0000, v84
    v_lshlrev_b32 v18, 16, v88
    v_and_b32 v19, 0xffff0000, v88
    v_pk_mul_f32 v[16:17], v[16:17], v[18:19]
    v_cvt_pk_bf16_f32 v16, v16, v17
    v_lshlrev_b32 v17, 16, v16
    v_and_b32 v16, 0xffff0000, v16
    v_add_f32 v24, v16, v17
    v_lshlrev_b32 v16, 16, v85
    v_and_b32 v17, 0xffff0000, v85
    v_lshlrev_b32 v18, 16, v89
    v_and_b32 v19, 0xffff0000, v89
    v_pk_mul_f32 v[16:17], v[16:17], v[18:19]
    v_cvt_pk_bf16_f32 v16, v16, v17
    v_lshlrev_b32 v17, 16, v16
    v_and_b32 v16, 0xffff0000, v16
    v_add_f32 v24, v24, v16
    v_add_f32 v24, v24, v17
    v_lshlrev_b32 v16, 16, v86
    v_and_b32 v17, 0xffff0000, v86
    v_lshlrev_b32 v18, 16, v90
    v_and_b32 v19, 0xffff0000, v90
    v_pk_mul_f32 v[16:17], v[16:17], v[18:19]
    v_cvt_pk_bf16_f32 v16, v16, v17
    v_lshlrev_b32 v17, 16, v16
    v_and_b32 v16, 0xffff0000, v16
    v_add_f32 v24, v24, v16
    v_add_f32 v24, v24, v17
    v_lshlrev_b32 v16, 16, v87
    v_and_b32 v17, 0xffff0000, v87
    v_lshlrev_b32 v18, 16, v91
    v_and_b32 v19, 0xffff0000, v91
    v_pk_mul_f32 v[16:17], v[16:17], v[18:19]
    v_cvt_pk_bf16_f32 v16, v16, v17
    v_lshlrev_b32 v17, 16, v16
    v_and_b32 v16, 0xffff0000, v16
    v_add_f32 v24, v24, v16
    v_add_f32 v24, v24, v17
    s_nop 1
    v_add_f32_dpp v24, v24, v24 quad_perm:[1,0,3,2] row_mask:0xf bank_mask:0xf
    s_nop 1
    v_add_f32_dpp v24, v24, v24 quad_perm:[2,3,0,1] row_mask:0xf bank_mask:0xf
    s_nop 1
    v_add_f32_dpp v24, v24, v24 row_half_mirror row_mask:0xf bank_mask:0xf
    s_nop 1
    v_add_f32_dpp v24, v24, v24 row_ror:8 row_mask:0xf bank_mask:0xf
    s_nop 1
    v_add_f32_dpp v24, v24, v24 row_bcast:15 row_mask:0xa bank_mask:0xf
    s_nop 1
    v_add_f32_dpp v24, v24, v24 row_bcast:31 row_mask:0xc bank_mask:0xf
    v_cvt_pk_bf16_f32 v24, v24, v24
    v_and_b32 v24, 0xffff0000, v24
    v_mul_f32 v24, 0xbfb8aa3b, v24
    v_exp_f32 v24, v24
    s_nop 0
    v_add_f32 v24, 1.0, v24
    v_rcp_f32 v24, v24
    s_nop 0
    v_cvt_pk_bf16_f32 v24, v24, v24
    v_and_b32 v24, 0xffff0000, v24
    v_sub_f32 v25, 1.0, v24
    v_cvt_pk_bf16_f32 v25, v25, v25
    v_and_b32 v25, 0xffff0000, v25
    s_bfm_b64 exec, 1, 63
    ds_write_b64 v92, v[24:25] offset:512
    s_mov_b64 exec, -1
L_f_nog2:
    v_mov_b32 v20, 0
    v_mov_b32 v21, 0
    v_mov_b32 v22, 0
    v_mov_b32 v23, 0
    s_mov_b32 s58, 300
    s_mov_b32 s92, s40
    s_waitcnt vmcnt(0)
L_p0:
    s_sub_u32 s58, s58, 1
    s_cbranch_scc1 L_p0_to
L_p0_ld:
    buffer_load_dwordx4 v[16:19], v2, s[48:51], s56 offen sc1
    s_mov_b32 exec_hi, s95
    buffer_load_dwordx4 v[20:23], v2, s[48:51], s56 offen offset:1024 sc1
    s_and_b32 s44, s92, 0xffff
    s_lshr_b32 s45, s92, 16
    s_waitcnt vmcnt(0)
    v_perm_b32 v28, v21, v20, s63
    v_perm_b32 v29, v23, v22, s63
    v_cmp_ne_u64 s[60:61], s[44:45], v[28:29]
    s_mov_b32 exec_hi, -1
    v_perm_b32 v26, v17, v16, s63
    v_perm_b32 v27, v19, v18, s63
    v_cmp_ne_u64 vcc, s[44:45], v[26:27]
    s_or_b64 vcc, vcc, s[60:61]
    s_cbranch_scc1 L_p0
    v_and_b32 v16, 0xffffff00, v16
    v_and_b32 v17, 0xffffff00, v17
    v_and_b32 v18, 0xffffff00, v18
    v_and_b32 v19, 0xffffff00, v19
    v_and_b32 v20, 0xffffff00, v20
    v_and_b32 v21, 0xffffff00, v21
    v_and_b32 v22, 0xffffff00, v22
    v_and_b32 v23, 0xffffff00, v23
    v_add_f32_dpp v16, v16, v16 quad_perm:[1,0,3,2] row_mask:0xf bank_mask:0xf
    v_add_f32_dpp v17, v17, v17 quad_perm:[1,0,3,2] row_mask:0xf bank_mask:0xf
    v_add_f32_dpp v18, v18, v18 quad_perm:[1,0,3,2] row_mask:0xf bank_mask:0xf
    v_add_f32_dpp v19, v19, v19 quad_perm:[1,0,3,2] row_mask:0xf bank_mask:0xf
    v_add_f32_dpp v20, v20, v20 quad_perm:[1,0,3,2] row_mask:0xf bank_mask:0xf
    v_add_f32_dpp v21, v21, v21 quad_perm:[1,0,3,2] row_mask:0xf bank_mask:0xf
    v_add_f32_dpp v22, v22, v22 quad_perm:[1,0,3,2] row_mask:0xf bank_mask:0xf
    v_add_f32_dpp v23, v23, v23 quad_perm:[1,0,3,2] row_mask:0xf bank_mask:0xf
    v_add_f32_dpp v16, v16, v16 quad_perm:[2,3,0,1] row_mask:0xf bank_mask:0xf
    v_add_f32_dpp v17, v17, v17 quad_perm:[2,3,0,1] row_mask:0xf bank_mask:0xf
    v_add_f32_dpp v18, v18, v18 quad_perm:[2,3,0,1] row_mask:0xf bank_mask:0xf
    v_add_f32_dpp v19, v19, v19 quad_perm:[2,3,0,1] row_mask:0xf bank_mask:0xf
    v_add_f32_dpp v20, v20, v20 quad_perm:[2,3,0,1] row_mask:0xf bank_mask:0xf
    v_add_f32_dpp v21, v21, v21 quad_perm:[2,3,0,1] row_mask:0xf bank_mask:0xf
    v_add_f32_dpp v22, v22, v22 quad_perm:[2,3,0,1] row_mask:0xf bank_mask:0xf
    v_add_f32_dpp v23, v23, v23 quad_perm:[2,3,0,1] row_mask:0xf bank_mask:0xf
    v_add_f32_dpp v16, v16, v16 row_half_mirror row_mask:0xf bank_mask:0xf
    v_add_f32_dpp v17, v17, v17 row_half_mirror row_mask:0xf bank_mask:0xf
    v_add_f32_dpp v18, v18, v18 row_half_mirror row_mask:0xf bank_mask:0xf
    v_add_f32_dpp v19, v19, v19 row_half_mirror row_mask:0xf bank_mask:0xf
    v_add_f32_dpp v20, v20, v20 row_half_mirror row_mask:0xf bank_mask:0xf
    v_add_f32_dpp v21, v21, v21 row_half_mirror row_mask:0xf bank_mask:0xf
    v_add_f32_dpp v22, v22, v22 row_half_mirror row_mask:0xf bank_mask:0xf
    v_add_f32_dpp v23, v23, v23 row_half_mirror row_mask:0xf bank_mask:0xf
    v_cvt_pk_bf16_f32 v16, v16, v17
PAD1:
    s_cbranch_execz L_back
    v_cvt_pk_bf16_f32 v17, v18, v19
    v_cvt_pk_bf16_f32 v18, v20, v21
    v_cvt_pk_bf16_f32 v19, v22, v23
    s_lshl_b32 s55, s3, 7
    v_lshl_add_u32 v1, v9, 3, s55
    ds_write_b64 v1, v[16:17]
    ds_write_b64 v1, v[18:19] offset:64
    s_cmp_lt_u32 s3, 2
    s_cselect_b32 s55, 1, 256
    v_mov_b32 v1, s55
    s_mov_b64 exec, 1
    ds_add_u32 v92, v1 offset:520
    s_mov_b64 exec, -1
    s_mul_i32 s52, s62, 4224
    s_add_u32 s52, s52, 266240
    s_lshl_b32 s53, s3, 10
    s_add_u32 s53, s53, s52
    s_lshl_b32 s54, s30, 7
    s_add_u32 s54, s54, s53
    s_add_u32 s52, s52, 4096
    s_lshl4_add_u32 s97, s30, s52
    v_lshlrev_b32 v13, 4, v10
    v_mov_b32 v12, v2
    v_lshrrev_b32 v46, 4, v0
    v_lshl_add_u32 v14, v46, 3, v10
    v_lshlrev_b32 v14, 2, v14
    v_and_b32 v47, 15, v0
    v_lshlrev_b32 v47, 3, v47
    v_lshl_add_u32 v47, v46, 8, v47
    s_mov_b64 exec, 1
    global_load_dword v95, v94, s[26:27] sc1
    buffer_load_dword v84, v92, s[48:51], s54 offen sc1
    buffer_load_dword v85, v92, s[48:51], s52 offen sc1
    s_mov_b64 exec, -1
    s_mov_b32 s32, s12
    s_and_b32 s33, s13, 0xffff
    s_mov_b32 s34, 0x400000
    s_lshl_b32 s55, s31, 17
    s_lshl_b32 s56, s3, 15
    s_add_u32 s55, s55, s56
    s_lshl_b32 s56, s30, 7
    s_add_u32 s55, s55, s56
    v_lshl_add_u32 v1, v9, 11, v13
    v_lshl_add_u32 v2, v9, 10, v13
    s_add_u32 s57, s46, s3
    s_lshl_b32 s57, s57, 13
    s_add_u32 s56, s56, s57
    s_add_u32 s57, s3, 4
    s_cmp_lt_u32 s57, s47
    s_mov_b32 s57, 0x40000000
    s_cselect_b32 s57, 0x8000, s57
    v_add_u32 v56, s57, v2
    s_lshl_b32 s57, s3, 4
    v_lshl_add_u32 v3, v9, 1, s57
    s_add_u32 s61, s55, 0x4000
    s_cmp_lg_u32 s30, 3
    s_cbranch_scc1 L_f_np3
    buffer_load_dwordx4 v[24:27], v1, s[32:35], s55 offen offset:0 nt
    buffer_load_dwordx4 v[32:35], v1, s[32:35], s55 offen offset:1024 nt
L_f_np3:
L_wg:
    ds_read_b32 v15, v92 offset:520
    ds_read_u16 v40, v3 offset:256
    ds_read_u16 v41, v3 offset:384
    ds_read_u16 v42, v3 offset:320
    ds_read_u16 v43, v3 offset:448
    ds_read_b64 v[44:45], v92 offset:512
    s_sub_u32 s93, s93, 1
    s_cbranch_scc1 L_end
    s_waitcnt lgkmcnt(0)
    v_readfirstlane_b32 s60, v15
    s_bfe_u32 s60, s60, 0x40008
    s_cmp_ge_u32 s60, 2
    s_cbranch_scc0 L_wg
    v_lshlrev_b32 v40, 16, v40
    v_lshlrev_b32 v41, 16, v41
    v_max_f32 v40, 0, v40
    v_mul_f32 v40, v40, v41
    v_cvt_pk_bf16_f32 v40, v40, v40
    v_and_b32 v48, v40, v4
    v_and_b32 v49, v40, v5
    v_and_b32 v50, v40, v6
    v_and_b32 v51, v40, v7
    v_lshlrev_b32 v42, 16, v42
    v_lshlrev_b32 v43, 16, v43
    v_max_f32 v42, 0, v42
    v_mul_f32 v42, v42, v43
    v_cvt_pk_bf16_f32 v42, v42, v42
    v_and_b32 v52, v42, v4
    v_and_b32 v53, v42, v5
    v_and_b32 v54, v42, v6
    v_and_b32 v55, v42, v7
    v_mul_u32_u24 v46, 640, v9
    s_lshl_b32 s57, s3, 7
    v_add3_u32 v46, v46, v13, s57
    v_bfe_u32 v3, v0, 4, 1
    v_lshl_add_u32 v3, v10, 1, v3
    v_lshlrev_b32 v3, 4, v3
    v_lshrrev_b32 v11, 5, v0
    v_lshl_add_u32 v3, v11, 8, v3
    s_lshl_b32 s57, s3, 9
    v_add_u32 v3, s57, v3
    v_lshlrev_b32 v11, 3, v10
    v_lshlrev_b32 v57, 2, v9
    v_and_b32 v59, 24, v11
    v_lshrrev_b32 v58, v59, s40
    s_cmp_eq_u32 s59, 0
    s_cselect_b32 s58, 300, 0
    s_mov_b32 s59, 0
    s_mov_b32 s92, s40
    s_and_b32 s44, s92, 0xffff
    s_lshr_b32 s45, s92, 16
L_wm:
    ds_read_b32 v15, v92 offset:520
    ds_read_b64 v[76:77], v11 offset:528
    s_sub_u32 s93, s93, 1
    s_cbranch_scc1 L_end
    s_waitcnt lgkmcnt(0)
    v_readfirstlane_b32 s60, v15
    s_bfe_u32 s60, s60, 0x4000c
    s_cmp_ge_u32 s60, 8
    s_cbranch_scc0 L_wm
    v_mov_b32 v93, v77
    v_max_f32_dpp v77, v77, v77 quad_perm:[1,0,3,2] row_mask:0xf bank_mask:0xf
    s_nop 1
    v_max_f32_dpp v77, v77, v77 quad_perm:[2,3,0,1] row_mask:0xf bank_mask:0xf
    s_nop 1
    v_max_f32_dpp v77, v77, v77 row_half_mirror row_mask:0xf bank_mask:0xf
    v_sub_f32 v93, v93, v77
    v_mul_f32 v93, 0x3fb8aa3b, v93
    v_exp_f32 v93, v93
    v_mov_b32 v78, 0
    v_mul_f32 v76, v76, v93
    v_mov_b32 v79, 0
    ds_bpermute_b32 v93, v57, v93
    v_add_f32_dpp v76, v76, v76 quad_perm:[1,0,3,2] row_mask:0xf bank_mask:0xf
    s_nop 1
    v_add_f32_dpp v76, v76, v76 quad_perm:[2,3,0,1] row_mask:0xf bank_mask:0xf
    s_nop 1
    v_add_f32_dpp v76, v76, v76 row_half_mirror row_mask:0xf bank_mask:0xf
    v_bfi_b32 v76, v8, s40, v76
    v_bfi_b32 v77, v8, s41, v77
    v_bfi_b32 v78, v8, s42, v78
    v_bfi_b32 v79, v8, s43, v79
    s_cmp_lg_u32 s3, 0
    s_cbranch_scc1 L_f_nolm
    s_mov_b64 exec, 1
    buffer_store_dwordx4 v[76:79], v92, s[48:51], s97 offen
    s_mov_b64 exec, -1
L_f_nolm:
    s_lshl2_add_u32 s60, s30, s3
    s_cmp_lg_u32 s60, 3
    s_cbranch_scc1 L_f_noep
    v_mov_b32 v60, s94
    s_mov_b64 exec, 1
    buffer_store_dword v60, v92, s[48:51], s90 offen
    s_mov_b64 exec, -1
L_f_noep:
L_wx:
    ds_read_b32 v15, v92 offset:520
    s_sub_u32 s93, s93, 1
    s_cbranch_scc1 L_end
    s_waitcnt lgkmcnt(0)
    v_readfirstlane_b32 s60, v15
    s_bfe_u32 s60, s60, 0x40004
    s_cmp_ge_u32 s60, 8
    s_cbranch_scc0 L_wx
PAD2:
    s_cbranch_execz L_back
    s_mov_b64 exec, 0xff
    buffer_load_dwordx4 v[84:87], v13, s[48:51], s52 offen sc1
    s_mov_b64 exec, -1
    s_cmp_eq_u32 s30, 3
    s_cbranch_scc1 L_f_p3
    buffer_load_dwordx4 v[24:27], v1, s[32:35], s55 offen offset:0 nt
    buffer_load_dwordx4 v[32:35], v1, s[32:35], s55 offen offset:1024 nt
L_f_p3:
    buffer_load_dwordx4 v[16:19], v2, s[36:39], s56 offen nt
    buffer_load_dwordx4 v[20:23], v56, s[36:39], s56 offen nt
    buffer_load_dwordx4 v[28:31], v1, s[32:35], s61 offen offset:0 nt
    buffer_load_dwordx4 v[36:39], v1, s[32:35], s61 offen offset:1024 nt
    s_cmp_ge_u32 s3, 2
    s_cbranch_scc1 L_f_aok
    s_waitcnt vmcnt(9)
L_f_achk:
    v_readfirstlane_b32 s60, v95
    s_cmp_eq_u32 s60, 0
    s_cbranch_scc1 L_acc_re
    v_lshrrev_b32 v95, 1, v0
    s_lshl_b32 s60, s3, 5
    v_add_u32 v95, s60, v95
    v_and_b32 v94, 1, v0
    v_lshlrev_b32 v94, 10, v94
    v_lshl_add_u32 v94, v95, 2, v94
    s_lshl_b32 s60, s30, 7
    v_lshl_add_u32 v95, v95, 1, s60
    s_mov_b32 s88, 0xaaaaaaaa
    s_mov_b32 s89, s88
    s_mov_b32 s90, 0
    s_mov_b32 s91, 0x403f0000
L_f_aok:
    s_mov_b32 s86, 0x00ff00ff
    s_mov_b32 s87, s86
    s_barrier
    ds_read_b128 v[64:67], v46 offset:768
    s_waitcnt lgkmcnt(0)
    v_pk_mul_f32 v[64:65], v[64:65], v[92:93] op_sel:[0,1] op_sel_hi:[1,1]
    v_pk_mul_f32 v[66:67], v[66:67], v[92:93] op_sel:[0,1] op_sel_hi:[1,1]
    s_nop 1
    v_permlane32_swap_b32 v64, v66
    v_permlane32_swap_b32 v65, v67
    v_pk_add_f32 v[64:65], v[64:65], v[66:67]
    s_nop 1
    v_permlane16_swap_b32 v64, v65
    v_add_f32 v64, v64, v65
    s_nop 1
    v_add_f32_dpp v64, v64, v64 row_ror:8 row_mask:0xf bank_mask:0xf
    s_mov_b64 exec, s[86:87]
    v_bfi_b32 v64, v8, v58, v64
    buffer_store_dword v64, v14, s[48:51], s54 offen
    s_mov_b64 exec, 0xff
    buffer_load_dwordx4 v[72:75], v13, s[48:51], s52 offen sc1
    s_mov_b64 exec, -1
    s_waitcnt vmcnt(4)
    v_mfma_f32_16x16x32_bf16 v[80:83], v[48:51], v[16:19], 0
    v_mfma_f32_16x16x32_bf16 v[80:83], v[52:55], v[20:23], v[80:83]
    s_nop 7
    v_pk_mul_f32 v[80:81], v[80:81], v[44:45] op_sel:[0,1] op_sel_hi:[1,1]
    v_pk_mul_f32 v[82:83], v[82:83], v[44:45] op_sel:[0,1] op_sel_hi:[1,1]
    buffer_load_dwordx4 v[68:71], v12, s[48:51], s53 offen sc1
    v_perm_b32 v42, v85, v84, s63
    v_perm_b32 v43, v87, v86, s63
    v_cmp_ne_u64 vcc, s[44:45], v[42:43]
    v_and_b32 v85, 0xffff0000, v85
    s_and_b32 vcc_lo, vcc_lo, 0xff
    s_cbranch_scc1 L_p1_c
    v_max_f32_dpp v86, v85, v85 quad_perm:[1,0,3,2] row_mask:0xf bank_mask:0xf
    v_and_b32 v84, 0xffffff00, v84
    s_nop 0
    v_max_f32_dpp v86, v86, v86 quad_perm:[2,3,0,1] row_mask:0xf bank_mask:0xf
    s_nop 1
    v_max_f32_dpp v86, v86, v86 row_half_mirror row_mask:0xf bank_mask:0xf
    v_sub_f32 v85, v85, v86
    v_mul_f32 v85, 0x3fb8aa3b, v85
    v_exp_f32 v85, v85
    s_nop 0
    v_mul_f32 v84, v85, v84
    ds_bpermute_b32 v43, v57, v85
    s_nop 0
    v_add_f32_dpp v84, v84, v84 quad_perm:[1,0,3,2] row_mask:0xf bank_mask:0xf
    s_nop 1
    v_add_f32_dpp v84, v84, v84 quad_perm:[2,3,0,1] row_mask:0xf bank_mask:0xf
    s_nop 1
    v_add_f32_dpp v84, v84, v84 row_half_mirror row_mask:0xf bank_mask:0xf
    v_rcp_f32 v84, v84
    s_nop 0
    v_mul_f32 v84, v44, v84
    s_nop 0
    v_readfirstlane_b32 s60, v84
    s_waitcnt vmcnt(0)
    v_perm_b32 v40, v69, v68, s63
    v_perm_b32 v41, v71, v70, s63
    v_cmp_ne_u64 vcc, s[44:45], v[40:41]
    s_cmp_eq_u64 vcc, 0
    s_cbranch_scc1 L_p1_go
    s_mov_b64 exec, vcc
    buffer_load_dwordx4 v[68:71], v12, s[48:51], s53 offen sc1
    s_branch L_p1b
L_p1_c:
    s_waitcnt vmcnt(1) lgkmcnt(0)
    v_perm_b32 v42, v73, v72, s63
    v_perm_b32 v43, v75, v74, s63
    v_cmp_ne_u64 vcc, s[44:45], v[42:43]
    v_and_b32 v73, 0xffff0000, v73
    s_and_b32 vcc_lo, vcc_lo, 0xff
    s_cbranch_scc1 L_p1
    v_max_f32_dpp v74, v73, v73 quad_perm:[1,0,3,2] row_mask:0xf bank_mask:0xf
    v_and_b32 v72, 0xffffff00, v72
    s_nop 0
    v_max_f32_dpp v74, v74, v74 quad_perm:[2,3,0,1] row_mask:0xf bank_mask:0xf
    s_nop 1
    v_max_f32_dpp v74, v74, v74 row_half_mirror row_mask:0xf bank_mask:0xf
    v_sub_f32 v73, v73, v74
    v_mul_f32 v73, 0x3fb8aa3b, v73
    v_exp_f32 v73, v73
    s_waitcnt vmcnt(0)
    ds_bpermute_b32 v43, v57, v73
    v_mul_f32 v72, v73, v72
    v_perm_b32 v40, v69, v68, s63
    v_perm_b32 v41, v71, v70, s63
    v_add_f32_dpp v72, v72, v72 quad_perm:[1,0,3,2] row_mask:0xf bank_mask:0xf
    v_cmp_ne_u64 s[46:47], s[44:45], v[40:41]
    s_cmp_eq_u64 s[46:47], 0
    s_cbranch_scc1 L_p1_all
    s_mov_b64 exec, s[46:47]
    buffer_load_dwordx4 v[68:71], v12, s[48:51], s53 offen sc1
    s_mov_b64 exec, -1
L_p1_all:
    v_add_f32_dpp v72, v72, v72 quad_perm:[2,3,0,1] row_mask:0xf bank_mask:0xf
    s_nop 1
    v_add_f32_dpp v72, v72, v72 row_half_mirror row_mask:0xf bank_mask:0xf
    v_rcp_f32 v72, v72
    s_nop 0
    v_mul_f32 v72, v44, v72
    s_nop 0
    v_readfirstlane_b32 s60, v72
    s_cbranch_scc1 L_p1_go
    s_mov_b64 exec, s[46:47]
L_p1b:
    buffer_load_dwordx4 v[68:71], v12, s[48:51], s53 offen sc1
    s_sub_u32 s58, s58, 1
    s_cbranch_scc1 L_p1_to
    s_waitcnt vmcnt(1)
    v_perm_b32 v40, v69, v68, s63
    v_perm_b32 v41, v71, v70, s63
    v_cmp_ne_u64 vcc, s[44:45], v[40:41]
    s_and_b64 exec, exec, vcc
    s_cbranch_scc1 L_p1b
    s_mov_b64 exec, -1
L_p1_go:
    v_and_b32 v88, 0xffffff00, v68
    v_and_b32 v89, 0xffffff00, v69
    v_and_b32 v90, 0xffffff00, v70
    v_and_b32 v91, 0xffffff00, v71
    s_waitcnt lgkmcnt(0)
    v_pk_mul_f32 v[88:89], v[88:89], v[42:43] op_sel:[0,1] op_sel_hi:[1,1]
    v_pk_mul_f32 v[90:91], v[90:91], v[42:43] op_sel:[0,1] op_sel_hi:[1,1]
    s_nop 1
    v_permlane32_swap_b32 v88, v90
    v_permlane32_swap_b32 v89, v91
    v_pk_add_f32 v[88:89], v[88:89], v[90:91]
    s_nop 1
    v_permlane16_swap_b32 v88, v89
    v_add_f32 v88, v88, v89
    s_nop 1
    v_add_f32_dpp v88, v88, v88 row_ror:8 row_mask:0xf bank_mask:0xf
    v_mul_f32 v88, s60, v88
    v_cvt_pk_bf16_f32 v88, v88, v88
    s_nop 1
    v_mov_b32_dpp v88, v88 row_ror:4 row_mask:0xf bank_mask:0x6
    s_nop 1
    v_and_b32_dpp v48, v88, v4 quad_perm:[0,0,0,0] row_mask:0xf bank_mask:0xf
    v_and_b32_dpp v49, v88, v5 quad_perm:[0,0,0,0] row_mask:0xf bank_mask:0xf
    v_and_b32_dpp v50, v88, v6 quad_perm:[0,0,0,0] row_mask:0xf bank_mask:0xf
    v_and_b32_dpp v51, v88, v7 quad_perm:[0,0,0,0] row_mask:0xf bank_mask:0xf
    v_and_b32_dpp v52, v88, v4 quad_perm:[1,1,1,1] row_mask:0xf bank_mask:0xf
    v_and_b32_dpp v53, v88, v5 quad_perm:[1,1,1,1] row_mask:0xf bank_mask:0xf
    v_and_b32_dpp v54, v88, v6 quad_perm:[1,1,1,1] row_mask:0xf bank_mask:0xf
    v_and_b32_dpp v55, v88, v7 quad_perm:[1,1,1,1] row_mask:0xf bank_mask:0xf
    v_mfma_f32_16x16x32_bf16 v[80:83], v[48:51], v[24:27], v[80:83]
    v_and_b32_dpp v56, v88, v4 quad_perm:[2,2,2,2] row_mask:0xf bank_mask:0xf
    v_and_b32_dpp v57, v88, v5 quad_perm:[2,2,2,2] row_mask:0xf bank_mask:0xf
    v_and_b32_dpp v58, v88, v6 quad_perm:[2,2,2,2] row_mask:0xf bank_mask:0xf
    v_and_b32_dpp v59, v88, v7 quad_perm:[2,2,2,2] row_mask:0xf bank_mask:0xf
    v_mfma_f32_16x16x32_bf16 v[80:83], v[52:55], v[28:31], v[80:83]
    v_and_b32_dpp v60, v88, v4 quad_perm:[3,3,3,3] row_mask:0xf bank_mask:0xf
    v_and_b32_dpp v61, v88, v5 quad_perm:[3,3,3,3] row_mask:0xf bank_mask:0xf
    v_and_b32_dpp v62, v88, v6 quad_perm:[3,3,3,3] row_mask:0xf bank_mask:0xf
    v_and_b32_dpp v63, v88, v7 quad_perm:[3,3,3,3] row_mask:0xf bank_mask:0xf
    v_mfma_f32_16x16x32_bf16 v[80:83], v[56:59], v[32:35], v[80:83]
PAD3:
    s_cbranch_execz L_back
    v_mfma_f32_16x16x32_bf16 v[80:83], v[60:63], v[36:39], v[80:83]
    s_mov_b32 exec_lo, 0x00ff00ff
    s_mov_b32 exec_hi, 0xff00ff00
    s_cmp_ge_u32 s3, 2
    s_nop 4
    ds_write_b128 v3, v[80:83] offset:5888
    s_mov_b64 exec, -1
    s_waitcnt lgkmcnt(0)
    s_barrier
    s_cbranch_scc1 L_f_fin
    ds_read2st64_b32 v[16:17], v94 offset0:23 offset1:24
    ds_read2st64_b32 v[18:19], v94 offset0:25 offset1:26
    s_waitcnt lgkmcnt(0)
    v_pk_add_f32 v[16:17], v[16:17], v[18:19]
    v_add_f32 v16, v16, v17
    s_nop 1
    v_add_f32_dpp v16, v16, v16 quad_perm:[1,0,3,2] row_mask:0xf bank_mask:0xf
    v_cndmask_b32 v16, v16, 1.0, s[88:89]
    v_cvt_f64_f32 v[20:21], v16
    buffer_atomic_add_f64 v[20:21], v47, s[48:51], s96 offen sc0 sc1
    v_cvt_f64_f32 v[18:19], v16
    s_waitcnt vmcnt(0)
    v_add_f64 v[18:19], v[18:19], v[20:21]
    v_cmp_eq_u64 vcc, s[90:91], v[20:21]
    v_cvt_f32_f64 v16, v[18:19]
    s_and_b64 vcc, vcc, s[88:89]
    v_cvt_pk_bf16_f32 v16, v16, v16
    s_lshr_b64 exec, vcc, 1
    s_cbranch_execz L_f_fin
    global_store_short v95, v16, s[24:25]
L_f_fin:
    s_endpgm
.fill 222, 4, 0xbf810000
L_kv:
    v_and_b32 v2, 1, v0
    v_lshlrev_b32 v2, 4, v2
    v_mov_b32 v3, 0xffff
    v_lshlrev_b32 v2, v2, v3
    v_bfe_u32 v3, v0, 1, 2
    v_cmp_eq_u32 vcc, 0, v3
    s_nop 1
    v_cndmask_b32 v4, 0, v2, vcc
    v_cmp_eq_u32 vcc, 1, v3
    s_nop 1
    v_cndmask_b32 v5, 0, v2, vcc
    v_cmp_eq_u32 vcc, 2, v3
    s_nop 1
    v_cndmask_b32 v6, 0, v2, vcc
    v_cmp_eq_u32 vcc, 3, v3
    s_nop 1
    v_cndmask_b32 v7, 0, v2, vcc
    v_and_b32 v2, 15, v0
    v_lshlrev_b32 v3, 4, v2
    v_lshrrev_b32 v9, 4, v0
    s_mul_i32 s57, s3, 640
    v_lshl_add_u32 v11, v2, 1, v9
    v_lshl_add_u32 v11, v11, 4, s57
    s_lshl_b32 s57, s3, 3
    v_mov_b32 v2, s57
    s_waitcnt vmcnt(2)
    buffer_load_dwordx4 v[44:47], v1, s[32:35], s54 offen nt
    s_add_u32 s54, s54, s56
    s_and_b32 s54, s54, s55
    s_waitcnt vmcnt(2)
    buffer_load_dwordx4 v[48:51], v1, s[32:35], s54 offen nt
    s_add_u32 s54, s54, s56
    s_and_b32 s54, s54, s55
    s_waitcnt vmcnt(2)
    buffer_load_dwordx4 v[52:55], v1, s[32:35], s54 offen nt
    s_add_u32 s54, s54, s56
    s_and_b32 s54, s54, s55
    s_waitcnt vmcnt(2)
    buffer_load_dwordx4 v[56:59], v1, s[32:35], s54 offen nt
    s_add_u32 s54, s54, s56
    s_and_b32 s54, s54, s55
    s_waitcnt vmcnt(2)
    buffer_load_dwordx4 v[60:63], v1, s[32:35], s54 offen nt
    s_add_u32 s54, s54, s56
    s_and_b32 s54, s54, s55
    s_waitcnt vmcnt(2)
    buffer_load_dwordx4 v[64:67], v1, s[36:39], s54 offen nt
    s_add_u32 s54, s54, s56
    s_and_b32 s54, s54, s55
    s_waitcnt vmcnt(2)
    buffer_load_dwordx4 v[68:71], v1, s[36:39], s54 offen nt
    s_add_u32 s54, s54, s56
    s_and_b32 s54, s54, s55
    s_waitcnt vmcnt(2)
    buffer_load_dwordx4 v[72:75], v1, s[36:39], s54 offen nt
    s_add_u32 s54, s54, s56
    s_and_b32 s54, s54, s55
    s_waitcnt vmcnt(2)
    buffer_load_dwordx4 v[76:79], v1, s[36:39], s54 offen nt
    s_add_u32 s54, s54, s56
    s_and_b32 s54, s54, s55
    s_waitcnt vmcnt(2)
    buffer_load_dwordx4 v[80:83], v1, s[36:39], s54 offen nt
    s_add_u32 s54, s54, s56
    s_and_b32 s54, s54, s55
    s_waitcnt vmcnt(2)
    buffer_load_dwordx4 v[84:87], v1, s[36:39], s54 offen nt
    s_add_u32 s54, s54, s56
    s_and_b32 s54, s54, s55
L_wq:
    ds_read_b32 v10, v8 offset:520
    ds_read_b128 v[12:15], v3
    s_sub_u32 s93, s93, 1
    s_cbranch_scc1 L_end
    s_waitcnt lgkmcnt(0)
    v_readfirstlane_b32 s60, v10
    s_bfe_u32 s60, s60, 0x40000
    s_cmp_ge_u32 s60, 2
    s_cbranch_scc0 L_wq
    s_setprio 1
    s_waitcnt vmcnt(6)
    v_dot2_f32_bf16 v16, v32, v12, 0
    v_dot2_f32_bf16 v17, v36, v12, 0
    v_dot2_f32_bf16 v18, v40, v12, 0
    v_dot2_f32_bf16 v19, v44, v12, 0
    v_dot2_f32_bf16 v20, v48, v12, 0
    v_dot2_f32_bf16 v21, v52, v12, 0
    v_dot2_f32_bf16 v22, v56, v12, 0
    v_dot2_f32_bf16 v23, v60, v12, 0
    v_dot2_f32_bf16 v16, v33, v13, v16
    v_dot2_f32_bf16 v17, v37, v13, v17
    v_dot2_f32_bf16 v18, v41, v13, v18
    v_dot2_f32_bf16 v19, v45, v13, v19
    v_dot2_f32_bf16 v20, v49, v13, v20
    v_dot2_f32_bf16 v21, v53, v13, v21
    v_dot2_f32_bf16 v22, v57, v13, v22
    v_dot2_f32_bf16 v23, v61, v13, v23
    v_dot2_f32_bf16 v16, v34, v14, v16
    v_dot2_f32_bf16 v17, v38, v14, v17
    v_dot2_f32_bf16 v18, v42, v14, v18
    v_dot2_f32_bf16 v19, v46, v14, v19
    v_dot2_f32_bf16 v20, v50, v14, v20
    v_dot2_f32_bf16 v21, v54, v14, v21
    v_dot2_f32_bf16 v22, v58, v14, v22
    v_dot2_f32_bf16 v23, v62, v14, v23
    v_dot2_f32_bf16 v16, v35, v15, v16
    v_dot2_f32_bf16 v17, v39, v15, v17
    v_dot2_f32_bf16 v18, v43, v15, v18
    v_dot2_f32_bf16 v19, v47, v15, v19
    v_dot2_f32_bf16 v20, v51, v15, v20
    v_dot2_f32_bf16 v21, v55, v15, v21
    v_dot2_f32_bf16 v22, v59, v15, v22
    v_dot2_f32_bf16 v23, v63, v15, v23
    v_add_f32_dpp v16, v16, v16 row_ror:8 row_mask:0xf bank_mask:0x3
    v_add_f32_dpp v17, v17, v17 row_ror:8 row_mask:0xf bank_mask:0x3
    v_add_f32_dpp v18, v18, v18 row_ror:8 row_mask:0xf bank_mask:0x3
    v_add_f32_dpp v19, v19, v19 row_ror:8 row_mask:0xf bank_mask:0x3
    v_add_f32_dpp v16, v20, v20 row_ror:8 row_mask:0xf bank_mask:0xc
    v_add_f32_dpp v17, v21, v21 row_ror:8 row_mask:0xf bank_mask:0xc
    v_add_f32_dpp v18, v22, v22 row_ror:8 row_mask:0xf bank_mask:0xc
    v_add_f32_dpp v19, v23, v23 row_ror:8 row_mask:0xf bank_mask:0xc
    v_add_f32_dpp v16, v16, v16 row_half_mirror row_mask:0xf bank_mask:0x5
    v_add_f32_dpp v17, v17, v17 row_half_mirror row_mask:0xf bank_mask:0x5
    v_add_f32_dpp v16, v18, v18 row_half_mirror row_mask:0xf bank_mask:0xa
    v_add_f32_dpp v17, v19, v19 row_half_mirror row_mask:0xf bank_mask:0xa
    s_nop 0
    v_add_f32_dpp v16, v16, v16 quad_perm:[1,0,3,2] row_mask:0xf bank_mask:0xf
    v_add_f32_dpp v17, v17, v17 quad_perm:[1,0,3,2] row_mask:0xf bank_mask:0xf
    s_nop 0
    v_add_f32_dpp v16, v16, v16 quad_perm:[2,3,0,1] row_mask:0xf bank_mask:0xf
    v_add_f32_dpp v17, v17, v17 quad_perm:[2,3,0,1] row_mask:0xf bank_mask:0xf
    v_cvt_pk_bf16_f32 v17, v16, v17
    v_lshlrev_b32 v16, 16, v17
    v_and_b32 v17, 0xffff0000, v17
    v_mul_f32 v16, 0x3db504f3, v16
    v_mul_f32 v17, 0x3db504f3, v17
    v_cvt_pk_bf16_f32 v17, v16, v17
    v_lshlrev_b32 v16, 16, v17
    v_and_b32 v17, 0xffff0000, v17
    v_max_f32 v25, v16, v17
    s_nop 1
    v_max_f32_dpp v25, v25, v25 row_ror:4 row_mask:0xf bank_mask:0xf
    s_nop 1
    v_max_f32_dpp v25, v25, v25 row_ror:8 row_mask:0xf bank_mask:0xf
    s_nop 1
    v_max_f32_dpp v25, v25, v25 row_bcast:15 row_mask:0xa bank_mask:0xf
    s_nop 1
    v_max_f32_dpp v25, v25, v25 row_bcast:31 row_mask:0xc bank_mask:0xf
    s_nop 0
    v_readlane_b32 s57, v25, 63
    s_nop 1
    v_subrev_f32 v16, s57, v16
    v_subrev_f32 v17, s57, v17
    v_mul_f32 v16, 0x3fb8aa3b, v16
    v_mul_f32 v17, 0x3fb8aa3b, v17
    v_exp_f32 v16, v16
    v_exp_f32 v17, v17
    v_mov_b32 v10, 4096
    v_add_f32 v24, v16, v17
    v_cvt_pk_bf16_f32 v16, v16, v16
    v_cvt_pk_bf16_f32 v17, v17, v17
    v_add_f32_dpp v24, v24, v24 row_ror:4 row_mask:0xf bank_mask:0xf
    v_and_b32_dpp v32, v16, v4 row_newbcast:0 row_mask:0xf bank_mask:0xf
    v_and_b32_dpp v33, v16, v5 row_newbcast:0 row_mask:0xf bank_mask:0xf
    v_add_f32_dpp v24, v24, v24 row_ror:8 row_mask:0xf bank_mask:0xf
    v_and_b32_dpp v34, v16, v6 row_newbcast:0 row_mask:0xf bank_mask:0xf
    v_and_b32_dpp v35, v16, v7 row_newbcast:0 row_mask:0xf bank_mask:0xf
    v_add_f32_dpp v24, v24, v24 row_bcast:15 row_mask:0xa bank_mask:0xf
    v_and_b32_dpp v36, v17, v4 row_newbcast:0 row_mask:0xf bank_mask:0xf
    v_and_b32_dpp v37, v17, v5 row_newbcast:0 row_mask:0xf bank_mask:0xf
    v_add_f32_dpp v24, v24, v24 row_bcast:31 row_mask:0xc bank_mask:0xf
    v_and_b32_dpp v38, v17, v6 row_newbcast:0 row_mask:0xf bank_mask:0xf
    v_and_b32_dpp v39, v17, v7 row_newbcast:0 row_mask:0xf bank_mask:0xf
    s_bfm_b64 exec, 1, 63
    ds_write_b64 v2, v[24:25] offset:528
    ds_add_u32 v8, v10 offset:520
PAD4:
    s_cbranch_execz L_back
    s_mov_b64 exec, -1
    s_waitcnt vmcnt(3)
    buffer_load_dwordx4 v[88:91], v1, s[36:39], s54 offen nt
    s_add_u32 s54, s54, s56
    s_and_b32 s54, s54, s55
    s_waitcnt vmcnt(3)
    buffer_load_dwordx4 v[92:95], v1, s[36:39], s54 offen nt
    v_mov_b32 v26, 16
    s_mov_b64 exec, 1
    ds_add_u32 v8, v26 offset:520
    s_mov_b64 exec, -1
    v_and_b32_dpp v40, v16, v4 row_newbcast:4 row_mask:0xf bank_mask:0xf
    v_and_b32_dpp v41, v16, v5 row_newbcast:4 row_mask:0xf bank_mask:0xf
    v_and_b32_dpp v42, v16, v6 row_newbcast:4 row_mask:0xf bank_mask:0xf
    v_and_b32_dpp v43, v16, v7 row_newbcast:4 row_mask:0xf bank_mask:0xf
    v_and_b32_dpp v44, v17, v4 row_newbcast:4 row_mask:0xf bank_mask:0xf
    v_and_b32_dpp v45, v17, v5 row_newbcast:4 row_mask:0xf bank_mask:0xf
    v_and_b32_dpp v46, v17, v6 row_newbcast:4 row_mask:0xf bank_mask:0xf
    v_and_b32_dpp v47, v17, v7 row_newbcast:4 row_mask:0xf bank_mask:0xf
    v_and_b32_dpp v48, v16, v4 row_newbcast:8 row_mask:0xf bank_mask:0xf
    v_and_b32_dpp v49, v16, v5 row_newbcast:8 row_mask:0xf bank_mask:0xf
    v_and_b32_dpp v50, v16, v6 row_newbcast:8 row_mask:0xf bank_mask:0xf
    v_and_b32_dpp v51, v16, v7 row_newbcast:8 row_mask:0xf bank_mask:0xf
    v_and_b32_dpp v52, v17, v4 row_newbcast:8 row_mask:0xf bank_mask:0xf
    v_and_b32_dpp v53, v17, v5 row_newbcast:8 row_mask:0xf bank_mask:0xf
    v_and_b32_dpp v54, v17, v6 row_newbcast:8 row_mask:0xf bank_mask:0xf
    v_and_b32_dpp v55, v17, v7 row_newbcast:8 row_mask:0xf bank_mask:0xf
    v_and_b32_dpp v56, v16, v4 row_newbcast:12 row_mask:0xf bank_mask:0xf
    v_and_b32_dpp v57, v16, v5 row_newbcast:12 row_mask:0xf bank_mask:0xf
    v_and_b32_dpp v58, v16, v6 row_newbcast:12 row_mask:0xf bank_mask:0xf
    v_and_b32_dpp v59, v16, v7 row_newbcast:12 row_mask:0xf bank_mask:0xf
    v_and_b32_dpp v60, v17, v4 row_newbcast:12 row_mask:0xf bank_mask:0xf
    v_and_b32_dpp v61, v17, v5 row_newbcast:12 row_mask:0xf bank_mask:0xf
    v_and_b32_dpp v62, v17, v6 row_newbcast:12 row_mask:0xf bank_mask:0xf
    v_and_b32_dpp v63, v17, v7 row_newbcast:12 row_mask:0xf bank_mask:0xf
    s_waitcnt vmcnt(7)
    v_mfma_f32_16x16x32_bf16 v[28:31], v[32:35], v[64:67], 0
    s_waitcnt vmcnt(6)
    v_mfma_f32_16x16x32_bf16 v[28:31], v[36:39], v[68:71], v[28:31]
    s_waitcnt vmcnt(5)
    v_mfma_f32_16x16x32_bf16 v[28:31], v[40:43], v[72:75], v[28:31]
    s_waitcnt vmcnt(4)
    v_mfma_f32_16x16x32_bf16 v[28:31], v[44:47], v[76:79], v[28:31]
    s_waitcnt vmcnt(3)
    v_mfma_f32_16x16x32_bf16 v[28:31], v[48:51], v[80:83], v[28:31]
    s_waitcnt vmcnt(2)
    v_mfma_f32_16x16x32_bf16 v[28:31], v[52:55], v[84:87], v[28:31]
    s_waitcnt vmcnt(1)
    v_mfma_f32_16x16x32_bf16 v[28:31], v[56:59], v[88:91], v[28:31]
    s_waitcnt vmcnt(0)
    v_mfma_f32_16x16x32_bf16 v[28:31], v[60:63], v[92:95], v[28:31]
    s_mov_b32 exec_hi, 0
    s_nop 6
    ds_write_b128 v11, v[28:31] offset:768
    s_waitcnt lgkmcnt(0)
    s_barrier
L_end:
    s_endpgm
L_p1:
    s_sub_u32 s58, s58, 1
    s_cbranch_scc1 L_p1_to
L_p1_ld:
    s_mov_b64 exec, 0xff
    buffer_load_dwordx4 v[72:75], v13, s[48:51], s52 offen sc1
    s_mov_b64 exec, -1
    s_waitcnt vmcnt(0)
    s_branch L_p1_c
L_acc_re:
    s_sub_u32 s93, s93, 1
    s_cbranch_scc1 L_end
    global_load_dword v95, v94, s[26:27] sc1
    s_waitcnt vmcnt(0)
    s_branch L_f_achk
L_p0_to:
    s_sub_u32 s93, s93, 1
    s_cbranch_scc1 L_end
    s_cmp_lg_u32 s59, 0
    s_cbranch_scc1 L_p0_t2
    s_mov_b32 s59, 1
    s_mov_b32 exec_lo, s98
    s_mov_b32 exec_hi, 0
    s_lshr_b32 s60, s94, 24
    v_bfi_b32 v83, v8, s60, v83
    s_add_u32 s60, s57, 524288
    buffer_store_dwordx4 v[80:83], v1, s[48:51], s60 offen sc1
L_p0_t2:
    s_mov_b64 exec, -1
    s_xor_b32 s56, s56, 524288
    s_xor_b32 s92, s92, s99
    s_mov_b32 s58, 0
    s_branch L_p0_ld
L_p1_to:
    s_sub_u32 s93, s93, 1
    s_cbranch_scc1 L_end
    s_cmp_lg_u32 s59, 0
    s_cbranch_scc1 L_p1_t2
    s_mov_b32 s59, 1
    s_mov_b64 exec, s[86:87]
    v_lshrrev_b32 v58, v59, s94
    v_bfi_b32 v64, v8, v58, v64
    s_add_u32 s60, s54, 524288
    buffer_store_dword v64, v14, s[48:51], s60 offen sc1
    s_mov_b64 exec, 1
    s_lshr_b32 s60, s94, 24
    v_bfi_b32 v79, v8, s60, v79
    s_add_u32 s60, s97, 524288
    buffer_store_dwordx4 v[76:79], v92, s[48:51], s60 offen sc1
L_p1_t2:
    s_mov_b64 exec, -1
    s_xor_b32 s52, s52, 524288
    s_xor_b32 s53, s53, 524288
    s_xor_b32 s92, s92, s99
    s_mov_b32 s58, 0
    s_and_b32 s44, s92, 0xffff
    s_lshr_b32 s45, s92, 16
    buffer_load_dwordx4 v[68:71], v12, s[48:51], s53 offen sc1
    s_branch L_p1_ld
.section .rodata,"a"
.p2align 6
.amdhsa_kernel gated_mix__sliding_block_cached__glu_gated_reglu__decode_kernel
  .amdhsa_next_free_vgpr 96
  .amdhsa_next_free_sgpr 100
  .amdhsa_accum_offset 96
  .amdhsa_group_segment_fixed_size 0
  .amdhsa_kernarg_size 104
  .amdhsa_user_sgpr_count 2
  .amdhsa_user_sgpr_kernarg_segment_ptr 1
  .amdhsa_system_sgpr_workgroup_id_x 1
  .amdhsa_float_denorm_mode_32 3
.end_amdhsa_kernel
```
